```python
import torch

def _softmax(x, axis=-1):
    return torch.softmax(x, dim=axis)
def _gelu(x):
    return torch.nn.functional.gelu(x, approximate="tanh")
def _silu(x):
    return torch.nn.functional.silu(x)
def _sigmoid(x):
    return torch.sigmoid(x)
def _layernorm(x, axis=-1, eps=1e-5):
    m = x.mean(dim=axis, keepdim=True)
    v = x.var(dim=axis, keepdim=True, unbiased=False)
    return (x - m) / torch.sqrt(v + eps)
def _scatter_add(tgt, idx, src, axis=0):
    return tgt.clone().index_add_(axis, idx, src)
def _segment_sum(src, seg, n):
    out = torch.zeros((n,) + src.shape[1:], dtype=src.dtype)
    return out.index_add_(0, seg, src)
def _pad(x, pw):
    flat = tuple(v for pair in reversed(pw) for v in pair)
    return torch.nn.functional.pad(x, flat)

kernel_name = 'standalone__sliding_block_cached__decode'

def setup_inputs():

    _w = (lambda a: (lambda t: t.to(torch.bfloat16) if t.is_floating_point() else t)(torch.as_tensor(a)))
    B, Sq, D = 1, 1, 640
    Hq, Hkv, Sk, Dh = 32, 32, 32768, 192
    assert Hq % Hkv == 0, (Hq, Hkv)
    return {
        "x": _w((lambda *s: torch.randn(*s, dtype=torch.bfloat16) * 0.8)(B, Sq, D)),
        "k_cache": _w((lambda *s: torch.randn(*s, dtype=torch.bfloat16) * 0.8)(B, Hkv, Sk, Dh)),
        "v_cache": _w((lambda *s: torch.randn(*s, dtype=torch.bfloat16) * 0.05)(B, Hkv, Sk, Dh)),
        "wq": _w((lambda *s: torch.randn(*s, dtype=torch.bfloat16) * 0.8)(D, Hq * Dh) * (D ** -0.5)),
        "wo": _w((lambda *s: torch.randn(*s, dtype=torch.bfloat16) * 0.05)(Hq * Dh, D) * ((Hq * Dh) ** -0.5)),
    }

def reference(x, k_cache, v_cache, wq, wo):
    B, Sq, D = x.shape
    Hq, Dh = 32, 192
    Hkv, Sk = k_cache.shape[1], k_cache.shape[2]
    W = min(4096, max(256, Sk // 4))
    rep = Hq // Hkv
    q = (lambda x, *d: x.permute(*d))((x @ wq).reshape(B, Sq, Hq, Dh), 0, 2, 1, 3)
    k = (lambda x, n, axis: torch.repeat_interleave(x, n, dim=axis))(k_cache[:, :, Sk - W:, :], rep, axis=1)
    v = (lambda x, n, axis: torch.repeat_interleave(x, n, dim=axis))(v_cache[:, :, Sk - W:, :], rep, axis=1)
    scores = torch.einsum("bhqd,bhkd->bhqk", q, k) * (Dh ** -0.5)
    p = _softmax(scores, axis=-1)
    o = torch.einsum("bhqk,bhkd->bhqd", p, v)
    return (lambda x, *d: x.permute(*d))(o, 0, 2, 1, 3).reshape(B, Sq, Hq * Dh) @ wo
```

```asm
; @launch grid=(256,1,1) block=(512,1,1) lds=18944
.amdgcn_target "amdgcn-amd-amdhsa--gfx950"
.text
.globl standalone__sliding_block_cached__decode_kernel
.p2align 12
.p2align 8
.type standalone__sliding_block_cached__decode_kernel,@function
standalone__sliding_block_cached__decode_kernel:
    s_cmp_ge_u32 s2, 256
    s_cbranch_scc1 L_end
    s_load_dwordx2 s[32:33], s[0:1], 24
    s_load_dwordx2 s[20:21], s[0:1], 8
    s_load_dwordx2 s[40:41], s[0:1], 0
    v_lshrrev_b32 v50, 6, v0
    v_and_b32 v0, 63, v0
    v_readfirstlane_b32 s3, v50
    s_and_b32 s52, s2, 31
    s_lshr_b32 s53, s2, 5
    v_lshrrev_b32 v51, 3, v0
    v_and_b32 v50, 7, v0
    s_cmp_ge_u32 s3, 4
    s_cbranch_scc1 L_nowq
    s_mov_b32 s34, 7864320
    s_mov_b32 s35, 0x20000
    s_mul_i32 s12, s53, 160
    s_lshl4_add_u32 s12, s3, s12
    v_mul_u32_u24 v53, 12288, v51
    s_lshl4_add_u32 s6, s12, s52
    s_mulk_i32 s6, 384
    v_lshl_add_u32 v53, v50, 4, v53
    s_add_u32 s7, s6, 393216
    s_waitcnt lgkmcnt(0)
    buffer_load_dwordx4 v[160:163], v53, s[32:35], s6 offen offset:0 nt
    buffer_load_dwordx4 v[164:167], v53, s[32:35], s6 offen offset:128 nt
    buffer_load_dwordx4 v[168:171], v53, s[32:35], s6 offen offset:256 nt
    buffer_load_dwordx4 v[172:175], v53, s[32:35], s7 offen offset:0 nt
    buffer_load_dwordx4 v[176:179], v53, s[32:35], s7 offen offset:128 nt
    buffer_load_dwordx4 v[180:183], v53, s[32:35], s7 offen offset:256 nt
    s_mov_b32 s42, 1280
    s_mov_b32 s43, 0x20000
    v_lshlrev_b32 v54, 1, v51
    s_add_u32 s8, s6, 589824
    s_cmp_lt_u32 s3, 2
    buffer_load_ushort v56, v54, s[40:43], s12 offen offset:0
    buffer_load_ushort v57, v54, s[40:43], s12 offen offset:64
    s_cbranch_scc1 L_nowq
    buffer_load_dwordx4 v[184:187], v53, s[32:35], s8 offen offset:0 nt
    buffer_load_dwordx4 v[188:191], v53, s[32:35], s8 offen offset:128 nt
    buffer_load_dwordx4 v[192:195], v53, s[32:35], s8 offen offset:256 nt
    buffer_load_ushort v58, v54, s[40:43], s12 offen offset:96
L_nowq:
    s_mov_b32 s22, 402653184
    s_mov_b32 s23, 0x20000
    s_lshr_b32 s57, s3, 2
    s_mulk_i32 s57, 2044
    s_add_u32 s57, s57, s3
    v_mul_u32_u24 v1, 1536, v51
    s_lshl_b32 s58, s52, 9
    s_add_u32 s58, s58, s53
    s_lshl_b32 s58, s58, 6
    v_lshl_add_u32 v1, v50, 4, v1
    s_add_u32 s55, s57, s58
    s_addk_i32 s55, 28672
    s_mulk_i32 s55, 384
    s_mov_b32 s56, s55
    s_waitcnt lgkmcnt(0)
    buffer_load_dwordx4 v[64:67], v1, s[20:23], s55 offen offset:0 nt
    buffer_load_dwordx4 v[68:71], v1, s[20:23], s55 offen offset:128 nt
    buffer_load_dwordx4 v[72:75], v1, s[20:23], s55 offen offset:256 nt
    s_add_u32 s55, s55, 12288
    s_load_dwordx2 s[24:25], s[0:1], 16
    s_load_dwordx2 s[28:29], s[0:1], 56
    s_load_dwordx2 s[36:37], s[0:1], 32
    s_load_dwordx2 s[48:49], s[0:1], 40
    s_mov_b32 s26, 402653184
    s_mov_b32 s27, 0x20000
    s_mov_b32 s30, 1610612736
    s_mov_b32 s31, 0x20000
    s_mov_b32 s38, 7864320
    s_mov_b32 s39, 0x20000
    s_mov_b32 s50, 1280
    s_mov_b32 s51, 0x20000
    s_and_b32 s4, s3, 3
    s_lshl_b32 s62, s52, 3
    s_add_u32 s62, s62, s53
    s_lshl_b32 s62, s62, 2
    s_add_u32 s62, s62, s4
    s_lshl_b32 s62, s62, 8
    s_mov_b32 s60, 0x3fb8aa3b
    s_mov_b32 s61, 0x3d93cd3a
    s_mov_b32 s63, 400000
    s_getreg_b32 s54, hwreg(HW_REG_XCC_ID, 0, 4)
    v_and_b32 v51, 1, v0
    v_lshlrev_b32 v51, 4, v51
    v_mov_b32 v52, 0xffff
    v_lshlrev_b32 v52, v51, v52
    v_bfe_u32 v51, v0, 1, 2
    v_mov_b32 v26, 0
    v_cmp_eq_u32 vcc, 0, v51
    v_mov_b32 v18, 0
    v_mov_b32 v19, 0
    v_cndmask_b32 v2, 0, v52, vcc
    v_cmp_eq_u32 vcc, 1, v51
    v_mov_b32 v20, 0
    v_mov_b32 v21, 0
    v_cndmask_b32 v3, 0, v52, vcc
    v_cmp_eq_u32 vcc, 2, v51
    v_mov_b32 v22, 0
    v_mov_b32 v23, 0
    v_cndmask_b32 v4, 0, v52, vcc
    v_cmp_eq_u32 vcc, 3, v51
    v_mov_b32 v24, 0
    v_mov_b32 v25, 0
    v_cndmask_b32 v5, 0, v52, vcc
    v_lshrrev_b32 v51, 5, v0
    v_mul_u32_u24 v51, 768, v51
    v_and_b32 v52, 7, v0
    v_lshl_add_u32 v51, v52, 5, v51
    v_and_b32 v52, 16, v0
    v_add_u32 v51, v51, v52
    s_mul_i32 s57, s3, 1600
    s_add_u32 s57, s57, 1024
    v_add_u32 v48, s57, v51
    v_bfe_u32 v52, v0, 2, 2
    v_mul_u32_u24 v52, 1600, v52
    v_and_b32 v51, 3, v0
    v_lshlrev_b32 v51, 2, v51
    v_and_or_b32 v51, v0, 48, v51
    v_add_u32 v52, v51, v52
    s_lshl_b32 s57, s4, 6
    s_add_u32 s57, s57, 1024
    v_add_u32 v49, s57, v52
    v_lshlrev_b32 v55, 2, v51
    ds_write_b128 v26, v[20:23] offset:384
    ds_write_b128 v26, v[20:23] offset:400
    ds_write_b128 v26, v[20:23] offset:416
    v_mov_b32 v27, 1
    s_waitcnt lgkmcnt(0)
    s_barrier
    s_load_dword s68, s[28:29], 655360
    s_cmp_ge_u32 s3, 4
    s_cbranch_scc1 L_noqpub
    s_waitcnt vmcnt(3)
    v_lshl_or_b32 v56, v56, 16, v56
    v_lshl_or_b32 v57, v57, 16, v57
    v_and_b32 v28, v56, v2
    v_and_b32 v29, v56, v3
    v_and_b32 v30, v56, v4
    v_and_b32 v31, v56, v5
    v_and_b32 v32, v57, v2
    v_and_b32 v33, v57, v3
    v_and_b32 v34, v57, v4
    v_and_b32 v35, v57, v5
    v_lshl_or_b32 v58, v58, 16, v58
    v_mfma_f32_16x16x32_bf16 v[36:39], v[28:31], v[160:163], 0
    v_mfma_f32_16x16x32_bf16 v[40:43], v[28:31], v[164:167], 0
    v_mfma_f32_16x16x32_bf16 v[44:47], v[28:31], v[168:171], 0
    v_mfma_f32_16x16x32_bf16 v[36:39], v[32:35], v[172:175], v[36:39]
    v_mfma_f32_16x16x32_bf16 v[40:43], v[32:35], v[176:179], v[40:43]
    v_mfma_f32_16x16x32_bf16 v[44:47], v[32:35], v[180:183], v[44:47]
    s_cmp_lt_u32 s3, 2
    s_cbranch_scc1 L_nowq3
    v_and_b32 v28, v58, v2
    v_and_b32 v29, v58, v3
    v_and_b32 v30, v58, v4
    v_and_b32 v31, v58, v5
    s_nop 1
    v_mfma_f32_16x16x32_bf16 v[36:39], v[28:31], v[184:187], v[36:39]
    v_mfma_f32_16x16x32_bf16 v[40:43], v[28:31], v[188:191], v[40:43]
    v_mfma_f32_16x16x32_bf16 v[44:47], v[28:31], v[192:195], v[44:47]
L_nowq3:
    s_mov_b32 exec_lo, 0x00ff00ff
    s_mov_b32 exec_hi, 0xff00ff00
    s_nop 5
    ds_write_b128 v48, v[36:39] offset:0
    ds_write_b128 v48, v[40:43] offset:256
    ds_write_b128 v48, v[44:47] offset:512
    s_mov_b64 exec, 1
    ds_add_u32 v26, v27 offset:400
    s_mov_b64 exec, -1
L_wq:
    ds_read_b32 v52, v26 offset:400
    ds_read2st64_b32 v[36:37], v49 offset0:0 offset1:3
    ds_read2st64_b32 v[38:39], v49 offset0:1 offset1:4
    ds_read2st64_b32 v[40:41], v49 offset0:2 offset1:5
    s_waitcnt lgkmcnt(0)
    v_readfirstlane_b32 s57, v52
    s_cmp_lt_u32 s57, 4
    s_cbranch_scc1 L_wq
    v_add_u32 v63, s68, v27
    v_add_f32 v60, v36, v37
    v_add_f32 v61, v38, v39
    v_add_f32 v62, v40, v41
    v_add_f32_dpp v60, v60, v60 row_ror:4 row_mask:0xf bank_mask:0xf
    v_add_f32_dpp v61, v61, v61 row_ror:4 row_mask:0xf bank_mask:0xf
    v_add_f32_dpp v62, v62, v62 row_ror:4 row_mask:0xf bank_mask:0xf
    v_add_f32_dpp v60, v60, v60 row_ror:8 row_mask:0xf bank_mask:0xf
    v_add_f32_dpp v61, v61, v61 row_ror:8 row_mask:0xf bank_mask:0xf
    v_add_f32_dpp v62, v62, v62 row_ror:8 row_mask:0xf bank_mask:0xf
    v_and_or_b32 v62, v62, -16, s54
    s_mov_b32 exec_lo, 0x000f000f
    s_mov_b32 exec_hi, 0x000f000f
    buffer_store_dwordx4 v[60:63], v55, s[28:31], s62 offen
    s_cmp_lg_u32 s53, 7
    s_cbranch_scc1 L_noinit
    s_cmp_ge_u32 s52, 5
    s_cbranch_scc1 L_noinit
    v_and_b32 v57, 0x3ffff, v63
    v_lshlrev_b32 v57, 6, v57
    v_cvt_f32_u32 v57, v57
    v_mov_b32 v56, 0
    v_mov_b32 v58, 0
    v_mov_b32 v59, v57
    s_lshl_b32 s57, s52, 10
    s_lshl_b32 s58, s3, 8
    s_add_u32 s57, s57, s58
    s_add_u32 s57, s57, 524288
    buffer_store_dwordx4 v[56:59], v55, s[28:31], s57 offen sc1
L_noinit:
    s_mov_b64 exec, -1
L_noqpub:
    s_cmp_eq_u32 s3, 0
    s_cbranch_scc1 L_wave0
    buffer_load_dwordx4 v[76:79], v1, s[20:23], s55 offen offset:0 nt
    buffer_load_dwordx4 v[80:83], v1, s[20:23], s55 offen offset:128 nt
    buffer_load_dwordx4 v[84:87], v1, s[20:23], s55 offen offset:256 nt
    s_add_u32 s55, s55, 184320
    buffer_load_dwordx4 v[88:91], v1, s[20:23], s55 offen offset:0 nt
    buffer_load_dwordx4 v[92:95], v1, s[20:23], s55 offen offset:128 nt
    buffer_load_dwordx4 v[96:99], v1, s[20:23], s55 offen offset:256 nt
    s_add_u32 s55, s55, 12288
    buffer_load_dwordx4 v[100:103], v1, s[20:23], s55 offen offset:0 nt
    buffer_load_dwordx4 v[104:107], v1, s[20:23], s55 offen offset:128 nt
    buffer_load_dwordx4 v[108:111], v1, s[20:23], s55 offen offset:256 nt
    s_add_u32 s55, s55, 184320
    buffer_load_dwordx4 v[112:115], v1, s[20:23], s55 offen offset:0 nt
    buffer_load_dwordx4 v[116:119], v1, s[20:23], s55 offen offset:128 nt
    buffer_load_dwordx4 v[120:123], v1, s[20:23], s55 offen offset:256 nt
    s_add_u32 s55, s55, 12288
    buffer_load_dwordx4 v[124:127], v1, s[20:23], s55 offen offset:0 nt
    buffer_load_dwordx4 v[128:131], v1, s[20:23], s55 offen offset:128 nt
    buffer_load_dwordx4 v[132:135], v1, s[20:23], s55 offen offset:256 nt
    s_add_u32 s55, s55, 184320
    buffer_load_dwordx4 v[136:139], v1, s[20:23], s55 offen offset:0 nt
    buffer_load_dwordx4 v[140:143], v1, s[20:23], s55 offen offset:128 nt
    buffer_load_dwordx4 v[144:147], v1, s[20:23], s55 offen offset:256 nt
    s_add_u32 s55, s55, 12288
    buffer_load_dwordx4 v[148:151], v1, s[20:23], s55 offen offset:0 nt
    buffer_load_dwordx4 v[152:155], v1, s[20:23], s55 offen offset:128 nt
    buffer_load_dwordx4 v[156:159], v1, s[20:23], s55 offen offset:256 nt
    buffer_load_dwordx4 v[160:163], v1, s[24:27], s56 offen offset:0 nt
    buffer_load_dwordx4 v[164:167], v1, s[24:27], s56 offen offset:128 nt
    buffer_load_dwordx4 v[168:171], v1, s[24:27], s56 offen offset:256 nt
    s_add_u32 s56, s56, 12288
    buffer_load_dwordx4 v[172:175], v1, s[24:27], s56 offen offset:0 nt
    buffer_load_dwordx4 v[176:179], v1, s[24:27], s56 offen offset:128 nt
    buffer_load_dwordx4 v[180:183], v1, s[24:27], s56 offen offset:256 nt
    s_add_u32 s56, s56, 184320
    buffer_load_dwordx4 v[184:187], v1, s[24:27], s56 offen offset:0 nt
    buffer_load_dwordx4 v[188:191], v1, s[24:27], s56 offen offset:128 nt
    buffer_load_dwordx4 v[192:195], v1, s[24:27], s56 offen offset:256 nt
    s_add_u32 s56, s56, 12288
    buffer_load_dwordx4 v[196:199], v1, s[24:27], s56 offen offset:0 nt
    buffer_load_dwordx4 v[200:203], v1, s[24:27], s56 offen offset:128 nt
    buffer_load_dwordx4 v[204:207], v1, s[24:27], s56 offen offset:256 nt
    s_add_u32 s56, s56, 184320
    s_branch L_join
L_wave0:
    s_setprio 3
    v_lshlrev_b32 v56, 4, v0
    buffer_load_dwordx4 v[76:79], v1, s[20:23], s55 offen offset:0 nt
    buffer_load_dwordx4 v[80:83], v1, s[20:23], s55 offen offset:128 nt
    buffer_load_dwordx4 v[84:87], v1, s[20:23], s55 offen offset:256 nt
    s_add_u32 s55, s55, 184320
    buffer_load_dwordx4 v[88:91], v1, s[20:23], s55 offen offset:0 nt
    buffer_load_dwordx4 v[92:95], v1, s[20:23], s55 offen offset:128 nt
    buffer_load_dwordx4 v[96:99], v1, s[20:23], s55 offen offset:256 nt
    s_add_u32 s55, s55, 12288
    buffer_load_dwordx4 v[100:103], v1, s[20:23], s55 offen offset:0 nt
    buffer_load_dwordx4 v[104:107], v1, s[20:23], s55 offen offset:128 nt
    buffer_load_dwordx4 v[108:111], v1, s[20:23], s55 offen offset:256 nt
    s_add_u32 s55, s55, 184320
    buffer_load_dwordx4 v[112:115], v1, s[20:23], s55 offen offset:0 nt
    buffer_load_dwordx4 v[116:119], v1, s[20:23], s55 offen offset:128 nt
    buffer_load_dwordx4 v[120:123], v1, s[20:23], s55 offen offset:256 nt
    s_add_u32 s55, s55, 12288
    s_lshl_b32 s57, s52, 13
    buffer_load_dwordx4 v[220:223], v56, s[28:31], s57 offen offset:0 sc1
    buffer_load_dwordx4 v[224:227], v56, s[28:31], s57 offen offset:1024 sc1
    buffer_load_dwordx4 v[228:231], v56, s[28:31], s57 offen offset:2048 sc1
    buffer_load_dwordx4 v[232:235], v56, s[28:31], s57 offen offset:3072 sc1
    s_add_u32 s57, s57, 4096
    buffer_load_dwordx4 v[236:239], v56, s[28:31], s57 offen offset:0 sc1
    buffer_load_dwordx4 v[240:243], v56, s[28:31], s57 offen offset:1024 sc1
    buffer_load_dwordx4 v[244:247], v56, s[28:31], s57 offen offset:2048 sc1
    buffer_load_dwordx4 v[248:251], v56, s[28:31], s57 offen offset:3072 sc1
    buffer_load_dwordx4 v[124:127], v1, s[20:23], s55 offen offset:0 nt
    buffer_load_dwordx4 v[128:131], v1, s[20:23], s55 offen offset:128 nt
    buffer_load_dwordx4 v[132:135], v1, s[20:23], s55 offen offset:256 nt
    s_add_u32 s55, s55, 184320
    buffer_load_dwordx4 v[136:139], v1, s[20:23], s55 offen offset:0 nt
    buffer_load_dwordx4 v[140:143], v1, s[20:23], s55 offen offset:128 nt
    buffer_load_dwordx4 v[144:147], v1, s[20:23], s55 offen offset:256 nt
    s_add_u32 s55, s55, 12288
    buffer_load_dwordx4 v[148:151], v1, s[20:23], s55 offen offset:0 nt
    buffer_load_dwordx4 v[152:155], v1, s[20:23], s55 offen offset:128 nt
    buffer_load_dwordx4 v[156:159], v1, s[20:23], s55 offen offset:256 nt
    s_waitcnt vmcnt(9)
    s_mov_b32 s5, 0
L_chkq:
    v_xor_b32 v51, v223, v63
    v_xor_b32 v53, s54, v222
    v_xor_b32 v52, v227, v63
    v_xor_b32 v57, s54, v226
    v_or_b32 v51, v51, v52
    v_or_b32 v53, v53, v57
    v_xor_b32 v52, v231, v63
    v_xor_b32 v57, s54, v230
    v_or_b32 v51, v51, v52
    v_or_b32 v53, v53, v57
    v_xor_b32 v52, v235, v63
    v_xor_b32 v57, s54, v234
    v_or_b32 v51, v51, v52
    v_or_b32 v53, v53, v57
    v_xor_b32 v52, v239, v63
    v_xor_b32 v57, s54, v238
    v_or_b32 v51, v51, v52
    v_or_b32 v53, v53, v57
    v_xor_b32 v52, v243, v63
    v_xor_b32 v57, s54, v242
    v_or_b32 v51, v51, v52
    v_or_b32 v53, v53, v57
    v_xor_b32 v52, v247, v63
    v_xor_b32 v57, s54, v246
    v_or_b32 v51, v51, v52
    v_or_b32 v53, v53, v57
    v_xor_b32 v52, v251, v63
    v_xor_b32 v57, s54, v250
    v_or_b32 v51, v51, v52
    v_or_b32 v53, v53, v57
    v_and_b32 v53, 15, v53
    v_or_b32 v52, v51, v53
    v_cmp_ne_u32 vcc, 0, v52
    s_cbranch_vccz L_q_ok
    s_cmp_eq_u32 s5, 1
    s_cbranch_scc1 L_through
L_own:
    buffer_load_dwordx4 v[28:31], v56, s[28:31], s62 offen sc1
    s_waitcnt vmcnt(0)
    v_cmp_ne_u32 vcc, v31, v63
    s_sub_u32 s63, s63, 1
    s_cbranch_scc1 L_q_ok
    s_cbranch_vccnz L_own
    buffer_store_dwordx4 v[28:31], v56, s[28:31], s62 offen sc1
    s_mov_b32 s5, 1
L_through:
    v_cmp_ne_u32 vcc, 0, v51
    s_sub_u32 s63, s63, 1
    s_cbranch_scc1 L_q_ok
    s_cbranch_vccz L_q_ok
    s_lshl_b32 s57, s52, 13
    buffer_load_dwordx4 v[220:223], v56, s[28:31], s57 offen offset:0 sc1
    buffer_load_dwordx4 v[224:227], v56, s[28:31], s57 offen offset:1024 sc1
    buffer_load_dwordx4 v[228:231], v56, s[28:31], s57 offen offset:2048 sc1
    buffer_load_dwordx4 v[232:235], v56, s[28:31], s57 offen offset:3072 sc1
    s_add_u32 s57, s57, 4096
    buffer_load_dwordx4 v[236:239], v56, s[28:31], s57 offen offset:0 sc1
    buffer_load_dwordx4 v[240:243], v56, s[28:31], s57 offen offset:1024 sc1
    buffer_load_dwordx4 v[244:247], v56, s[28:31], s57 offen offset:2048 sc1
    buffer_load_dwordx4 v[248:251], v56, s[28:31], s57 offen offset:3072 sc1
    s_waitcnt vmcnt(0)
    s_branch L_chkq
L_q_ok:
    s_max_i32 s63, s63, 0
    v_cmp_eq_u32 vcc, 0, v53
    v_and_b32 v222, -16, v222
    v_and_b32 v226, -16, v226
    v_and_b32 v230, -16, v230
    v_and_b32 v234, -16, v234
    v_and_b32 v238, -16, v238
    v_and_b32 v242, -16, v242
    v_and_b32 v246, -16, v246
    v_and_b32 v250, -16, v250
    v_pk_add_f32 v[220:221], v[220:221], v[224:225]
    v_add_f32 v222, v222, v226
    v_pk_add_f32 v[220:221], v[220:221], v[228:229]
    v_add_f32 v222, v222, v230
    v_pk_add_f32 v[220:221], v[220:221], v[232:233]
    v_add_f32 v222, v222, v234
    v_pk_add_f32 v[220:221], v[220:221], v[236:237]
    v_add_f32 v222, v222, v238
    v_pk_add_f32 v[220:221], v[220:221], v[240:241]
    v_add_f32 v222, v222, v242
    v_pk_add_f32 v[220:221], v[220:221], v[244:245]
    v_add_f32 v222, v222, v246
    v_pk_add_f32 v[220:221], v[220:221], v[248:249]
    v_add_f32 v222, v222, v250
    v_mov_b32 v52, 2
    v_cndmask_b32 v52, 1, v52, vcc
    v_cvt_pk_bf16_f32 v56, v220, v221
    v_cvt_pk_bf16_f32 v57, v222, v222
    v_lshlrev_b32 v51, 1, v0
    ds_write_b16 v51, v56 offset:0
    ds_write_b16_d16_hi v51, v56 offset:128
    ds_write_b16 v51, v57 offset:256
    ds_write_b32 v26, v52 offset:384
    buffer_load_dwordx4 v[160:163], v1, s[24:27], s56 offen offset:0 nt
    buffer_load_dwordx4 v[164:167], v1, s[24:27], s56 offen offset:128 nt
    buffer_load_dwordx4 v[168:171], v1, s[24:27], s56 offen offset:256 nt
    s_add_u32 s56, s56, 12288
    buffer_load_dwordx4 v[172:175], v1, s[24:27], s56 offen offset:0 nt
    buffer_load_dwordx4 v[176:179], v1, s[24:27], s56 offen offset:128 nt
    buffer_load_dwordx4 v[180:183], v1, s[24:27], s56 offen offset:256 nt
    s_add_u32 s56, s56, 184320
    buffer_load_dwordx4 v[184:187], v1, s[24:27], s56 offen offset:0 nt
    buffer_load_dwordx4 v[188:191], v1, s[24:27], s56 offen offset:128 nt
    buffer_load_dwordx4 v[192:195], v1, s[24:27], s56 offen offset:256 nt
    s_add_u32 s56, s56, 12288
    buffer_load_dwordx4 v[196:199], v1, s[24:27], s56 offen offset:0 nt
    buffer_load_dwordx4 v[200:203], v1, s[24:27], s56 offen offset:128 nt
    buffer_load_dwordx4 v[204:207], v1, s[24:27], s56 offen offset:256 nt
    s_add_u32 s56, s56, 184320
    s_setprio 0
L_join:
    v_and_b32 v50, 7, v0
    v_lshlrev_b32 v54, 4, v50
L_waitq:
    ds_read_b32 v52, v26 offset:384
    ds_read_b128 v[6:9], v54 offset:0
    ds_read_b128 v[10:13], v54 offset:128
    ds_read_b128 v[14:17], v54 offset:256
    s_waitcnt lgkmcnt(0)
    v_readfirstlane_b32 s69, v52
    s_cmp_eq_u32 s69, 0
    s_cbranch_scc1 L_waitq
    s_waitcnt vmcnt(12)
    v_dot2c_f32_bf16 v18, v64, v6
    v_dot2c_f32_bf16 v19, v76, v6
    v_dot2c_f32_bf16 v20, v88, v6
    v_dot2c_f32_bf16 v21, v100, v6
    v_dot2c_f32_bf16 v22, v112, v6
    v_dot2c_f32_bf16 v23, v124, v6
    v_dot2c_f32_bf16 v24, v136, v6
    v_dot2c_f32_bf16 v25, v148, v6
    v_dot2c_f32_bf16 v18, v65, v7
    v_dot2c_f32_bf16 v19, v77, v7
    v_dot2c_f32_bf16 v20, v89, v7
    v_dot2c_f32_bf16 v21, v101, v7
    v_dot2c_f32_bf16 v22, v113, v7
    v_dot2c_f32_bf16 v23, v125, v7
    v_dot2c_f32_bf16 v24, v137, v7
    v_dot2c_f32_bf16 v25, v149, v7
    v_dot2c_f32_bf16 v18, v66, v8
    v_dot2c_f32_bf16 v19, v78, v8
    v_dot2c_f32_bf16 v20, v90, v8
    v_dot2c_f32_bf16 v21, v102, v8
    v_dot2c_f32_bf16 v22, v114, v8
    v_dot2c_f32_bf16 v23, v126, v8
    v_dot2c_f32_bf16 v24, v138, v8
    v_dot2c_f32_bf16 v25, v150, v8
    v_dot2c_f32_bf16 v18, v67, v9
    v_dot2c_f32_bf16 v19, v79, v9
    v_dot2c_f32_bf16 v20, v91, v9
    v_dot2c_f32_bf16 v21, v103, v9
    v_dot2c_f32_bf16 v22, v115, v9
    v_dot2c_f32_bf16 v23, v127, v9
    v_dot2c_f32_bf16 v24, v139, v9
    v_dot2c_f32_bf16 v25, v151, v9
    v_dot2c_f32_bf16 v18, v68, v10
    v_dot2c_f32_bf16 v19, v80, v10
    v_dot2c_f32_bf16 v20, v92, v10
    v_dot2c_f32_bf16 v21, v104, v10
    v_dot2c_f32_bf16 v22, v116, v10
    v_dot2c_f32_bf16 v23, v128, v10
    v_dot2c_f32_bf16 v24, v140, v10
    v_dot2c_f32_bf16 v25, v152, v10
    v_dot2c_f32_bf16 v18, v69, v11
    v_dot2c_f32_bf16 v19, v81, v11
    v_dot2c_f32_bf16 v20, v93, v11
    v_dot2c_f32_bf16 v21, v105, v11
    v_dot2c_f32_bf16 v22, v117, v11
    v_dot2c_f32_bf16 v23, v129, v11
    v_dot2c_f32_bf16 v24, v141, v11
    v_dot2c_f32_bf16 v25, v153, v11
    v_dot2c_f32_bf16 v18, v70, v12
    v_dot2c_f32_bf16 v19, v82, v12
    v_dot2c_f32_bf16 v20, v94, v12
    v_dot2c_f32_bf16 v21, v106, v12
    v_dot2c_f32_bf16 v22, v118, v12
    v_dot2c_f32_bf16 v23, v130, v12
    v_dot2c_f32_bf16 v24, v142, v12
    v_dot2c_f32_bf16 v25, v154, v12
    v_dot2c_f32_bf16 v18, v71, v13
    v_dot2c_f32_bf16 v19, v83, v13
    v_dot2c_f32_bf16 v20, v95, v13
    v_dot2c_f32_bf16 v21, v107, v13
    v_dot2c_f32_bf16 v22, v119, v13
    v_dot2c_f32_bf16 v23, v131, v13
    v_dot2c_f32_bf16 v24, v143, v13
    v_dot2c_f32_bf16 v25, v155, v13
    v_dot2c_f32_bf16 v18, v72, v14
    v_dot2c_f32_bf16 v19, v84, v14
    v_dot2c_f32_bf16 v20, v96, v14
    v_dot2c_f32_bf16 v21, v108, v14
    v_dot2c_f32_bf16 v22, v120, v14
    v_dot2c_f32_bf16 v23, v132, v14
    v_dot2c_f32_bf16 v24, v144, v14
    v_dot2c_f32_bf16 v25, v156, v14
    v_dot2c_f32_bf16 v18, v73, v15
    v_dot2c_f32_bf16 v19, v85, v15
    v_dot2c_f32_bf16 v20, v97, v15
    v_dot2c_f32_bf16 v21, v109, v15
    v_dot2c_f32_bf16 v22, v121, v15
    v_dot2c_f32_bf16 v23, v133, v15
    v_dot2c_f32_bf16 v24, v145, v15
    v_dot2c_f32_bf16 v25, v157, v15
    v_dot2c_f32_bf16 v18, v74, v16
    v_dot2c_f32_bf16 v19, v86, v16
    v_dot2c_f32_bf16 v20, v98, v16
    v_dot2c_f32_bf16 v21, v110, v16
    v_dot2c_f32_bf16 v22, v122, v16
    v_dot2c_f32_bf16 v23, v134, v16
    v_dot2c_f32_bf16 v24, v146, v16
    v_dot2c_f32_bf16 v25, v158, v16
    v_dot2c_f32_bf16 v18, v75, v17
    v_dot2c_f32_bf16 v19, v87, v17
    v_dot2c_f32_bf16 v20, v99, v17
    v_dot2c_f32_bf16 v21, v111, v17
    v_dot2c_f32_bf16 v22, v123, v17
    v_dot2c_f32_bf16 v23, v135, v17
    v_dot2c_f32_bf16 v24, v147, v17
    v_dot2c_f32_bf16 v25, v159, v17
    buffer_load_dwordx4 v[208:211], v1, s[24:27], s56 offen offset:0 nt
    buffer_load_dwordx4 v[212:215], v1, s[24:27], s56 offen offset:128 nt
    buffer_load_dwordx4 v[216:219], v1, s[24:27], s56 offen offset:256 nt
    s_add_u32 s56, s56, 12288
    v_add_f32_dpp v18, v18, v18 quad_perm:[1,0,3,2] row_mask:0xf bank_mask:0xf
    v_add_f32_dpp v19, v19, v19 quad_perm:[1,0,3,2] row_mask:0xf bank_mask:0xf
    v_add_f32_dpp v20, v20, v20 quad_perm:[1,0,3,2] row_mask:0xf bank_mask:0xf
    v_add_f32_dpp v21, v21, v21 quad_perm:[1,0,3,2] row_mask:0xf bank_mask:0xf
    v_add_f32_dpp v22, v22, v22 quad_perm:[1,0,3,2] row_mask:0xf bank_mask:0xf
    v_add_f32_dpp v23, v23, v23 quad_perm:[1,0,3,2] row_mask:0xf bank_mask:0xf
    v_add_f32_dpp v24, v24, v24 quad_perm:[1,0,3,2] row_mask:0xf bank_mask:0xf
    v_add_f32_dpp v25, v25, v25 quad_perm:[1,0,3,2] row_mask:0xf bank_mask:0xf
    v_add_f32_dpp v18, v18, v18 quad_perm:[2,3,0,1] row_mask:0xf bank_mask:0xf
    v_add_f32_dpp v19, v19, v19 quad_perm:[2,3,0,1] row_mask:0xf bank_mask:0xf
    v_add_f32_dpp v20, v20, v20 quad_perm:[2,3,0,1] row_mask:0xf bank_mask:0xf
    v_add_f32_dpp v21, v21, v21 quad_perm:[2,3,0,1] row_mask:0xf bank_mask:0xf
    v_add_f32_dpp v22, v22, v22 quad_perm:[2,3,0,1] row_mask:0xf bank_mask:0xf
    v_add_f32_dpp v23, v23, v23 quad_perm:[2,3,0,1] row_mask:0xf bank_mask:0xf
    v_add_f32_dpp v24, v24, v24 quad_perm:[2,3,0,1] row_mask:0xf bank_mask:0xf
    v_add_f32_dpp v25, v25, v25 quad_perm:[2,3,0,1] row_mask:0xf bank_mask:0xf
    v_add_f32_dpp v18, v18, v18 row_half_mirror row_mask:0xf bank_mask:0xf
    v_add_f32_dpp v19, v19, v19 row_half_mirror row_mask:0xf bank_mask:0xf
    v_add_f32_dpp v20, v20, v20 row_half_mirror row_mask:0xf bank_mask:0xf
    v_add_f32_dpp v21, v21, v21 row_half_mirror row_mask:0xf bank_mask:0xf
    v_add_f32_dpp v22, v22, v22 row_half_mirror row_mask:0xf bank_mask:0xf
    v_add_f32_dpp v23, v23, v23 row_half_mirror row_mask:0xf bank_mask:0xf
    v_add_f32_dpp v24, v24, v24 row_half_mirror row_mask:0xf bank_mask:0xf
    v_add_f32_dpp v25, v25, v25 row_half_mirror row_mask:0xf bank_mask:0xf
    v_cvt_pk_bf16_f32 v56, v18, v19
    v_cvt_pk_bf16_f32 v57, v20, v21
    v_cvt_pk_bf16_f32 v58, v22, v23
    v_cvt_pk_bf16_f32 v59, v24, v25
    v_lshlrev_b32 v18, 16, v56
    v_and_b32 v19, 0xffff0000, v56
    v_lshlrev_b32 v20, 16, v57
    v_and_b32 v21, 0xffff0000, v57
    v_lshlrev_b32 v22, 16, v58
    v_and_b32 v23, 0xffff0000, v58
    v_lshlrev_b32 v24, 16, v59
    v_and_b32 v25, 0xffff0000, v59
    v_mul_f32 v18, s61, v18
    v_mul_f32 v19, s61, v19
    v_mul_f32 v20, s61, v20
    v_mul_f32 v21, s61, v21
    v_mul_f32 v22, s61, v22
    v_mul_f32 v23, s61, v23
    v_mul_f32 v24, s61, v24
    v_mul_f32 v25, s61, v25
    v_cvt_pk_bf16_f32 v56, v18, v19
    v_cvt_pk_bf16_f32 v57, v20, v21
    v_cvt_pk_bf16_f32 v58, v22, v23
    v_cvt_pk_bf16_f32 v59, v24, v25
    v_lshlrev_b32 v18, 16, v56
    v_and_b32 v19, 0xffff0000, v56
    v_lshlrev_b32 v20, 16, v57
    v_and_b32 v21, 0xffff0000, v57
    v_lshlrev_b32 v22, 16, v58
    v_and_b32 v23, 0xffff0000, v58
    v_lshlrev_b32 v24, 16, v59
    v_and_b32 v25, 0xffff0000, v59
    v_max3_f32 v52, v18, v19, v20
    v_max3_f32 v53, v21, v22, v23
    v_max3_f32 v52, v52, v24, v25
    v_max_f32 v52, v52, v53
    s_nop 1
    v_max_f32_dpp v52, v52, v52 row_ror:8 row_mask:0xf bank_mask:0xf
    v_mov_b32 v53, v52
    s_nop 1
    v_permlane16_swap_b32 v53, v52
    v_max_f32 v52, v52, v53
    v_mov_b32 v53, v52
    s_nop 1
    v_permlane32_swap_b32 v53, v52
    v_max_f32 v52, v52, v53
    v_mul_f32 v58, s60, v52
    v_fma_f32 v18, v18, s60, -v58
    v_fma_f32 v19, v19, s60, -v58
    v_fma_f32 v20, v20, s60, -v58
    v_fma_f32 v21, v21, s60, -v58
    v_fma_f32 v22, v22, s60, -v58
    v_fma_f32 v23, v23, s60, -v58
    v_fma_f32 v24, v24, s60, -v58
    v_fma_f32 v25, v25, s60, -v58
    v_exp_f32 v18, v18
    v_exp_f32 v19, v19
    v_exp_f32 v20, v20
    v_exp_f32 v21, v21
    v_exp_f32 v22, v22
    v_exp_f32 v23, v23
    v_exp_f32 v24, v24
    v_exp_f32 v25, v25
    v_add_f32 v59, v18, v19
    v_add_f32 v53, v20, v21
    v_add_f32 v56, v22, v23
    v_add_f32 v57, v24, v25
    v_add_f32 v59, v59, v53
    v_add_f32 v56, v56, v57
    v_add_f32 v59, v59, v56
    s_nop 1
    v_add_f32_dpp v59, v59, v59 row_ror:8 row_mask:0xf bank_mask:0xf
    v_mov_b32 v53, v59
    s_nop 1
    v_permlane16_swap_b32 v53, v59
    v_add_f32 v59, v59, v53
    v_mov_b32 v53, v59
    s_nop 1
    v_permlane32_swap_b32 v53, v59
    v_add_f32 v59, v59, v53
    s_lshl_b32 s57, s3, 3
    v_mov_b32 v54, s57
    s_mov_b64 exec, 1
    ds_write_b64 v54, v[58:59] offset:512
    ds_add_u32 v26, v27 offset:388
    s_mov_b64 exec, -1
    buffer_load_dwordx4 v[220:223], v1, s[24:27], s56 offen offset:0 nt
    buffer_load_dwordx4 v[224:227], v1, s[24:27], s56 offen offset:128 nt
    buffer_load_dwordx4 v[228:231], v1, s[24:27], s56 offen offset:256 nt
    s_add_u32 s56, s56, 184320
    v_add_u32 v63, s68, v27
    s_lshl_b32 s67, s52, 13
    s_lshl_b32 s57, s4, 11
    s_add_u32 s67, s67, s57
    s_add_u32 s67, s67, 262144
    s_lshl_b32 s57, s53, 8
    s_add_u32 s62, s67, s57
    v_lshlrev_b32 v54, 3, v50
    v_cvt_pk_bf16_f32 v51, v18, v18
    v_and_b32 v28, v51, v2
    v_and_b32 v29, v51, v3
    v_and_b32 v30, v51, v4
    v_and_b32 v31, v51, v5
    s_waitcnt vmcnt(15)
    s_nop 0
    v_mfma_f32_16x16x32_bf16 v[36:39], v[28:31], v[160:163], 0
    v_mfma_f32_16x16x32_bf16 v[40:43], v[28:31], v[164:167], 0
    v_mfma_f32_16x16x32_bf16 v[44:47], v[28:31], v[168:171], 0
    buffer_load_dwordx4 v[232:235], v1, s[24:27], s56 offen offset:0 nt
    buffer_load_dwordx4 v[236:239], v1, s[24:27], s56 offen offset:128 nt
    buffer_load_dwordx4 v[240:243], v1, s[24:27], s56 offen offset:256 nt
    s_add_u32 s56, s56, 12288
    v_cvt_pk_bf16_f32 v51, v19, v19
    v_and_b32 v32, v51, v2
    v_and_b32 v33, v51, v3
    v_and_b32 v34, v51, v4
    v_and_b32 v35, v51, v5
    s_waitcnt vmcnt(15)
    s_nop 0
    v_mfma_f32_16x16x32_bf16 v[36:39], v[32:35], v[172:175], v[36:39]
    v_mfma_f32_16x16x32_bf16 v[40:43], v[32:35], v[176:179], v[40:43]
    v_mfma_f32_16x16x32_bf16 v[44:47], v[32:35], v[180:183], v[44:47]
    v_cvt_pk_bf16_f32 v51, v20, v20
    v_and_b32 v28, v51, v2
    v_and_b32 v29, v51, v3
    v_and_b32 v30, v51, v4
    v_and_b32 v31, v51, v5
    s_waitcnt vmcnt(12)
    s_nop 0
    v_mfma_f32_16x16x32_bf16 v[36:39], v[28:31], v[184:187], v[36:39]
    v_mfma_f32_16x16x32_bf16 v[40:43], v[28:31], v[188:191], v[40:43]
    v_mfma_f32_16x16x32_bf16 v[44:47], v[28:31], v[192:195], v[44:47]
    buffer_load_dwordx4 v[244:247], v1, s[24:27], s56 offen offset:0 nt
    buffer_load_dwordx4 v[248:251], v1, s[24:27], s56 offen offset:128 nt
    buffer_load_dwordx4 v[252:255], v1, s[24:27], s56 offen offset:256 nt
    s_mov_b64 exec, 1
    ds_add_u32 v26, v27 offset:404
    s_mov_b64 exec, -1
    v_cvt_pk_bf16_f32 v51, v21, v21
    v_and_b32 v32, v51, v2
    v_and_b32 v33, v51, v3
    v_and_b32 v34, v51, v4
    v_and_b32 v35, v51, v5
    s_waitcnt vmcnt(12)
    s_nop 0
    v_mfma_f32_16x16x32_bf16 v[36:39], v[32:35], v[196:199], v[36:39]
    v_mfma_f32_16x16x32_bf16 v[40:43], v[32:35], v[200:203], v[40:43]
    v_mfma_f32_16x16x32_bf16 v[44:47], v[32:35], v[204:207], v[44:47]
    v_cvt_pk_bf16_f32 v51, v22, v22
    v_and_b32 v28, v51, v2
    v_and_b32 v29, v51, v3
    v_and_b32 v30, v51, v4
    v_and_b32 v31, v51, v5
    s_waitcnt vmcnt(9)
    s_nop 0
    v_mfma_f32_16x16x32_bf16 v[36:39], v[28:31], v[208:211], v[36:39]
    v_mfma_f32_16x16x32_bf16 v[40:43], v[28:31], v[212:215], v[40:43]
    v_mfma_f32_16x16x32_bf16 v[44:47], v[28:31], v[216:219], v[44:47]
    s_cmp_lt_u32 s3, 4
    s_cbranch_scc1 L_old
    v_and_b32 v53, 12, v0
    v_lshlrev_b32 v53, 1, v53
L_wmly:
    ds_read_b32 v52, v26 offset:388
    ds_read_b64 v[56:57], v54 offset:512
    ds_read_b32 v59, v53 offset:512
    s_waitcnt lgkmcnt(0)
    v_readfirstlane_b32 s57, v52
    v_max_f32_dpp v52, v56, v56 quad_perm:[1,0,3,2] row_mask:0xf bank_mask:0xf
    s_cmp_lt_u32 s57, 8
    s_cbranch_scc1 L_wmly
    v_max_f32_dpp v52, v52, v52 quad_perm:[2,3,0,1] row_mask:0xf bank_mask:0xf
    s_nop 1
    v_max_f32_dpp v52, v52, v52 row_half_mirror row_mask:0xf bank_mask:0xf
    v_sub_f32 v56, v56, v52
    v_exp_f32 v56, v56
    v_sub_f32 v58, v58, v52
    v_mul_f32 v57, v57, v56
    v_exp_f32 v58, v58
    v_sub_f32 v59, v59, v52
    v_add_f32_dpp v57, v57, v57 quad_perm:[1,0,3,2] row_mask:0xf bank_mask:0xf
    s_nop 1
    v_add_f32_dpp v57, v57, v57 quad_perm:[2,3,0,1] row_mask:0xf bank_mask:0xf
    s_nop 1
    v_add_f32_dpp v57, v57, v57 row_half_mirror row_mask:0xf bank_mask:0xf
    s_nop 1
    v_exp_f32 v59, v59
    v_rcp_f32 v56, v57
    s_nop 0
    v_mul_f32 v58, v58, v56
    v_mul_f32 v59, v59, v56
    v_mul_f32 v23, v23, v58
    v_mul_f32 v24, v24, v58
    v_mul_f32 v25, v25, v58
    v_mul_f32 v36, v36, v58
    v_mul_f32 v37, v37, v58
    v_mul_f32 v38, v38, v58
    v_mul_f32 v39, v39, v58
    v_mul_f32 v40, v40, v58
    v_mul_f32 v41, v41, v58
    v_mul_f32 v42, v42, v58
    v_mul_f32 v43, v43, v58
    v_mul_f32 v44, v44, v58
    v_mul_f32 v45, v45, v58
    v_mul_f32 v46, v46, v58
    v_mul_f32 v47, v47, v58
    v_cvt_pk_bf16_f32 v51, v23, v23
    v_and_b32 v32, v51, v2
    v_and_b32 v33, v51, v3
    v_and_b32 v34, v51, v4
    v_and_b32 v35, v51, v5
    s_waitcnt vmcnt(6)
    s_nop 0
    v_mfma_f32_16x16x32_bf16 v[36:39], v[32:35], v[220:223], v[36:39]
    v_mfma_f32_16x16x32_bf16 v[40:43], v[32:35], v[224:227], v[40:43]
    v_mfma_f32_16x16x32_bf16 v[44:47], v[32:35], v[228:231], v[44:47]
    v_cvt_pk_bf16_f32 v51, v24, v24
    v_and_b32 v28, v51, v2
    v_and_b32 v29, v51, v3
    v_and_b32 v30, v51, v4
    v_and_b32 v31, v51, v5
    s_waitcnt vmcnt(3)
    s_nop 0
    v_mfma_f32_16x16x32_bf16 v[36:39], v[28:31], v[232:235], v[36:39]
    v_mfma_f32_16x16x32_bf16 v[40:43], v[28:31], v[236:239], v[40:43]
    v_mfma_f32_16x16x32_bf16 v[44:47], v[28:31], v[240:243], v[44:47]
    v_cvt_pk_bf16_f32 v51, v25, v25
    v_and_b32 v32, v51, v2
    v_and_b32 v33, v51, v3
    v_and_b32 v34, v51, v4
    v_and_b32 v35, v51, v5
    s_waitcnt vmcnt(0)
    s_nop 0
    v_mfma_f32_16x16x32_bf16 v[36:39], v[32:35], v[244:247], v[36:39]
    v_mfma_f32_16x16x32_bf16 v[40:43], v[32:35], v[248:251], v[40:43]
    v_mfma_f32_16x16x32_bf16 v[44:47], v[32:35], v[252:255], v[44:47]
    s_mov_b32 exec_lo, 0x00ff00ff
    s_mov_b32 exec_hi, 0xff00ff00
    s_nop 5
    ds_write_b128 v48, v[36:39] offset:0
    ds_write_b128 v48, v[40:43] offset:256
    ds_write_b128 v48, v[44:47] offset:512
    s_mov_b64 exec, 1
    ds_add_u32 v26, v27 offset:392
    s_mov_b64 exec, -1
    s_lshl_b32 s57, s4, 2
    v_mov_b32 v53, s57
L_wo:
    ds_read_b32 v52, v26 offset:392
    ds_read2st64_b32 v[36:37], v49 offset0:0 offset1:25
    ds_read2st64_b32 v[38:39], v49 offset0:3 offset1:28
    ds_read2st64_b32 v[40:41], v49 offset0:1 offset1:26
    ds_read2st64_b32 v[42:43], v49 offset0:4 offset1:29
    ds_read2st64_b32 v[44:45], v49 offset0:2 offset1:27
    ds_read2st64_b32 v[46:47], v49 offset0:5 offset1:30
    s_waitcnt lgkmcnt(6)
    v_readfirstlane_b32 s57, v52
    s_cmp_lt_u32 s57, 8
    s_cbranch_scc1 L_wo
    s_cmp_eq_u32 s69, 2
    s_waitcnt lgkmcnt(4)
    v_pk_add_f32 v[36:37], v[36:37], v[38:39]
    s_waitcnt lgkmcnt(2)
    v_pk_add_f32 v[40:41], v[40:41], v[42:43]
    s_waitcnt lgkmcnt(0)
    v_pk_add_f32 v[44:45], v[44:45], v[46:47]
    v_fma_f32 v60, v36, v59, v37
    v_fma_f32 v61, v40, v59, v41
    v_fma_f32 v62, v44, v59, v45
    v_add_f32_dpp v60, v60, v60 row_ror:4 row_mask:0xf bank_mask:0xf
    v_add_f32_dpp v61, v61, v61 row_ror:4 row_mask:0xf bank_mask:0xf
    v_add_f32_dpp v62, v62, v62 row_ror:4 row_mask:0xf bank_mask:0xf
    v_add_f32_dpp v60, v60, v60 row_ror:8 row_mask:0xf bank_mask:0xf
    v_add_f32_dpp v61, v61, v61 row_ror:8 row_mask:0xf bank_mask:0xf
    v_add_f32_dpp v62, v62, v62 row_ror:8 row_mask:0xf bank_mask:0xf
    s_mov_b32 exec_lo, 0x000f000f
    s_mov_b32 exec_hi, 0x000f000f
    s_cbranch_scc1 L_fast
    buffer_store_dwordx4 v[60:63], v55, s[28:31], s62 offen sc1
    s_branch L_pub
L_fast:
    buffer_store_dwordx4 v[60:63], v55, s[28:31], s62 offen
L_pub:
    ds_write_b32 v53, v27 offset:416
    s_endpgm
L_old:
    v_cvt_pk_bf16_f32 v51, v23, v23
    v_and_b32 v32, v51, v2
    v_and_b32 v33, v51, v3
    v_and_b32 v34, v51, v4
    v_and_b32 v35, v51, v5
    s_waitcnt vmcnt(6)
    s_nop 0
    v_mfma_f32_16x16x32_bf16 v[36:39], v[32:35], v[220:223], v[36:39]
    v_mfma_f32_16x16x32_bf16 v[40:43], v[32:35], v[224:227], v[40:43]
    v_mfma_f32_16x16x32_bf16 v[44:47], v[32:35], v[228:231], v[44:47]
    v_cvt_pk_bf16_f32 v51, v24, v24
    v_and_b32 v28, v51, v2
    v_and_b32 v29, v51, v3
    v_and_b32 v30, v51, v4
    v_and_b32 v31, v51, v5
    s_waitcnt vmcnt(3)
    s_nop 0
    v_mfma_f32_16x16x32_bf16 v[36:39], v[28:31], v[232:235], v[36:39]
    v_mfma_f32_16x16x32_bf16 v[40:43], v[28:31], v[236:239], v[40:43]
    v_mfma_f32_16x16x32_bf16 v[44:47], v[28:31], v[240:243], v[44:47]
    v_cvt_pk_bf16_f32 v51, v25, v25
    v_and_b32 v32, v51, v2
    v_and_b32 v33, v51, v3
    v_and_b32 v34, v51, v4
    v_and_b32 v35, v51, v5
    s_waitcnt vmcnt(0)
    s_nop 0
    v_mfma_f32_16x16x32_bf16 v[36:39], v[32:35], v[244:247], v[36:39]
    v_mfma_f32_16x16x32_bf16 v[40:43], v[32:35], v[248:251], v[40:43]
    v_mfma_f32_16x16x32_bf16 v[44:47], v[32:35], v[252:255], v[44:47]
    s_mov_b32 exec_lo, 0x00ff00ff
    s_mov_b32 exec_hi, 0xff00ff00
    s_nop 5
    ds_write_b128 v48, v[36:39] offset:0
    ds_write_b128 v48, v[40:43] offset:256
    ds_write_b128 v48, v[44:47] offset:512
    s_mov_b64 exec, 1
    ds_add_u32 v26, v27 offset:392
    s_mov_b64 exec, -1
    v_mov_b32 v6, v63
    s_lshl_b32 s66, s52, 7
    s_add_u32 s66, s66, 589824
    s_cmp_ge_u32 s53, 5
    s_cbranch_scc1 L_nosetup
    v_lshlrev_b32 v9, 2, v0
    s_lshl_b32 s5, s53, 10
    s_lshl_b32 s57, s3, 8
    s_add_u32 s5, s5, s57
    s_lshr_b32 s65, s5, 2
    s_add_u32 s5, s5, 524288
    buffer_load_dword v232, v9, s[28:31], s5 offen sc1
    buffer_load_ubyte v233, v0, s[48:51], s65 offen
    v_lshrrev_b32 v51, 4, v0
    v_and_b32 v52, 15, v0
    v_and_b32 v53, 2, v51
    v_add_u32 v51, v51, v53
    v_xor_b32 v53, 3, v51
    v_mul_u32_u24 v10, 1280, v51
    v_lshl_add_u32 v10, v52, 4, v10
    v_mul_u32_u24 v16, 1280, v53
    v_lshl_add_u32 v16, v52, 4, v16
    s_mul_i32 s6, s52, 245760
    s_mul_i32 s57, s3, 20480
    s_add_u32 s6, s6, s57
    s_lshl_b32 s57, s53, 8
    s_add_u32 s6, s6, s57
    s_add_u32 s7, s6, 10240
    s_add_u32 s8, s6, 81920
    s_add_u32 s9, s6, 92160
    s_add_u32 s10, s6, 163840
    s_add_u32 s11, s6, 174080
    v_and_b32 v13, 12, v0
    v_lshlrev_b32 v13, 2, v13
L_nosetup:
    s_cmp_lg_u32 s3, 1
    s_cbranch_scc1 L_nolse
    s_mul_i32 s57, s53, 0x12
    s_and_b32 s57, s57, 0x38
    s_add_u32 s58, s66, s57
L_wml:
    ds_read_b32 v52, v26 offset:388
    ds_read_b64 v[56:57], v54 offset:512
    s_waitcnt lgkmcnt(0)
    v_readfirstlane_b32 s57, v52
    v_max_f32_dpp v52, v56, v56 quad_perm:[1,0,3,2] row_mask:0xf bank_mask:0xf
    s_cmp_lt_u32 s57, 8
    s_cbranch_scc1 L_wml
    v_max_f32_dpp v52, v52, v52 quad_perm:[2,3,0,1] row_mask:0xf bank_mask:0xf
    s_nop 1
    v_max_f32_dpp v52, v52, v52 row_half_mirror row_mask:0xf bank_mask:0xf
    v_sub_f32 v56, v56, v52
    v_exp_f32 v56, v56
    s_cmp_eq_u32 s69, 2
    v_mul_f32 v57, v57, v56
    s_nop 1
    v_add_f32_dpp v57, v57, v57 quad_perm:[1,0,3,2] row_mask:0xf bank_mask:0xf
    s_nop 1
    v_add_f32_dpp v57, v57, v57 quad_perm:[2,3,0,1] row_mask:0xf bank_mask:0xf
    s_nop 1
    v_add_f32_dpp v57, v57, v57 row_half_mirror row_mask:0xf bank_mask:0xf
    v_log_f32 v57, v57
    s_mov_b64 exec, 1
    v_add_f32 v62, v57, v52
    s_cbranch_scc1 L_lfast
    buffer_store_dwordx2 v[62:63], v26, s[28:31], s58 offen sc1
    s_branch L_lpub
L_lfast:
    buffer_store_dwordx2 v[62:63], v26, s[28:31], s58 offen
L_lpub:
    s_mov_b64 exec, -1
L_nolse:
    s_cmp_ge_u32 s53, 5
    s_cbranch_scc1 L_cons
L_wv:
    ds_read_b32 v52, v26 offset:404
    s_waitcnt lgkmcnt(0)
    v_readfirstlane_b32 s57, v52
    s_cmp_lt_u32 s57, 8
    s_cbranch_scc1 L_wv
    buffer_load_dwordx4 v[64:67], v10, s[36:39], s6 offen offset:0 nt
    buffer_load_dwordx4 v[72:75], v16, s[36:39], s6 offen offset:0 nt
    buffer_load_dwordx4 v[68:71], v10, s[36:39], s7 offen offset:0 nt
    buffer_load_dwordx4 v[224:227], v13, s[28:31], s66 offen sc1
    buffer_load_dwordx4 v[76:79], v16, s[36:39], s7 offen offset:0 nt
    buffer_load_dwordx4 v[80:83], v10, s[36:39], s8 offen offset:0 nt
    buffer_load_dwordx4 v[88:91], v16, s[36:39], s8 offen offset:0 nt
    buffer_load_dwordx4 v[84:87], v10, s[36:39], s9 offen offset:0 nt
    buffer_load_dwordx4 v[92:95], v16, s[36:39], s9 offen offset:0 nt
    buffer_load_dwordx4 v[96:99], v10, s[36:39], s10 offen offset:0 nt
    buffer_load_dwordx4 v[100:103], v10, s[36:39], s11 offen offset:0 nt
    buffer_load_dwordx4 v[104:107], v16, s[36:39], s10 offen offset:0 nt
    buffer_load_dwordx4 v[108:111], v16, s[36:39], s11 offen offset:0 nt
    v_bfe_i32 v51, v0, 2, 1
    v_and_b32 v51, 48, v51
    v_xor_b32 v51, v51, v55
    v_lshl_add_u32 v50, v13, 4, v51
    s_mov_b32 s14, 0xffff
    s_mov_b32 s15, 0xffff
    v_and_b32 v12, 3, v0
    v_mul_u32_u24 v12, 0x5555, v12
    v_mov_b32 v36, 0
    v_mov_b32 v37, 0
    v_mov_b32 v38, 0
    v_mov_b32 v39, 0
    v_mov_b32 v40, 0
    v_mov_b32 v41, 0
    v_mov_b32 v42, 0
    v_mov_b32 v43, 0
    v_mov_b32 v160, 0
    v_mov_b32 v161, 0
    v_mov_b32 v162, 0
    v_mov_b32 v163, 0
    v_mov_b32 v164, 0
    v_mov_b32 v165, 0
    v_mov_b32 v166, 0
    v_mov_b32 v167, 0
    v_mov_b32 v168, 0
    v_mov_b32 v169, 0
    v_mov_b32 v170, 0
    v_mov_b32 v171, 0
    s_mul_i32 s57, s3, 1280
    s_add_u32 s57, s57, 13824
    v_and_b32 v51, 15, v0
    v_lshlrev_b32 v51, 5, v51
    v_lshrrev_b32 v52, 5, v0
    v_lshl_add_u32 v51, v52, 4, v51
    v_and_b32 v52, 16, v0
    v_mul_u32_u24 v52, 40, v52
    v_add3_u32 v7, s57, v51, v52
    s_mov_b32 s12, 0xaaaaaaaa
    s_mov_b32 s13, s12
    s_mov_b32 s16, 0x42000000
    s_lshl_b32 s57, s3, 7
    v_and_b32 v51, 62, v0
    v_lshl_add_u32 v51, v51, 1, s57
    v_and_b32 v52, 1, v0
    v_mul_u32_u24 v52, 640, v52
    v_add_u32 v51, v51, v52
    v_add_u32 v8, 13824, v51
    v_and_b32 v11, 0x3ffff, v6
    v_lshlrev_b32 v11, 6, v11
    v_cvt_f32_u32 v11, v11
    s_waitcnt vmcnt(13)
L_ck:
    v_sub_f32 v52, v232, v11
    v_cmp_le_f32 vcc, 0, v52
    v_cmp_gt_f32 s[18:19], s16, v52
    s_and_b64 vcc, vcc, s[18:19]
    s_andn2_b64 vcc, s[12:13], vcc
    s_cbranch_scc0 L_ckok
    s_sub_u32 s63, s63, 1
    s_cbranch_scc1 L_ckok
    buffer_load_dword v232, v9, s[28:31], s5 offen sc1
    s_waitcnt vmcnt(0)
    s_branch L_ck
L_ckok:
    s_max_i32 s63, s63, 0
    v_add_f32 v11, 0x41f80000, v11
    v_cndmask_b32 v11, -1, v11, s[12:13]
    s_lshl_b32 s57, s3, 2
    v_mov_b32 v54, s57
    s_waitcnt vmcnt(9)
    v_bitop3_b32 v51, v225, v227, v6 bitop3:0x7e
    v_max_f32 v52, v224, v226
    v_cmp_ne_u32 s[18:19], 0, v51
    s_nop 0
    v_max_f32_dpp v52, v52, v52 row_ror:4 row_mask:0xf bank_mask:0xf
    s_nop 1
    v_max_f32_dpp v52, v52, v52 row_ror:8 row_mask:0xf bank_mask:0xf
    v_sub_f32 v14, v224, v52
    v_sub_f32 v15, v226, v52
    v_exp_f32 v14, v14
    v_exp_f32 v15, v15
    s_nop 0
    v_add_f32 v52, v14, v15
    s_nop 1
    v_add_f32_dpp v52, v52, v52 row_ror:4 row_mask:0xf bank_mask:0xf
    s_nop 1
    v_add_f32_dpp v52, v52, v52 row_ror:8 row_mask:0xf bank_mask:0xf
    v_rcp_f32 v52, v52
    s_nop 0
    v_pk_mul_f32 v[14:15], v[14:15], v[52:53] op_sel_hi:[1,0]
L_gate:
    ds_read_b32 v52, v54 offset:416
    s_waitcnt lgkmcnt(0)
    v_readfirstlane_b32 s57, v52
    s_cmp_eq_u32 s57, 0
    s_cbranch_scc1 L_gate
    s_cmp_eq_u64 s[18:19], 0
    s_cbranch_scc1 L_poll1
L_poll0:
    buffer_load_dwordx4 v[224:227], v13, s[28:31], s66 offen sc1
    buffer_load_dwordx4 v[56:59], v50, s[28:31], s67 offen sc1
    buffer_load_dwordx4 v[60:63], v50, s[28:31], s67 offen offset:1024 sc1
    s_sub_u32 s63, s63, 1
    s_cbranch_scc1 L_fin
    s_waitcnt vmcnt(0)
    v_bitop3_b32 v51, v225, v227, v6 bitop3:0x7e
    v_bitop3_b32 v52, v59, v63, v6 bitop3:0x7e
    v_cmp_ne_u32 vcc, 0, v51
    v_cmp_ne_u32 s[18:19], 0, v52
    v_max_f32 v52, v224, v226
    s_cbranch_vccnz L_poll0
    s_cmp_eq_u64 s[18:19], 0
    s_cbranch_scc1 L_wgt
    buffer_load_dwordx4 v[56:59], v50, s[28:31], s67 offen sc1
    buffer_load_dwordx4 v[60:63], v50, s[28:31], s67 offen offset:1024 sc1
L_wgt:
    v_max_f32_dpp v52, v52, v52 row_ror:4 row_mask:0xf bank_mask:0xf
    s_nop 1
    v_max_f32_dpp v52, v52, v52 row_ror:8 row_mask:0xf bank_mask:0xf
    v_sub_f32 v14, v224, v52
    v_sub_f32 v15, v226, v52
    v_exp_f32 v14, v14
    v_exp_f32 v15, v15
    s_nop 0
    v_add_f32 v52, v14, v15
    s_nop 1
    v_add_f32_dpp v52, v52, v52 row_ror:4 row_mask:0xf bank_mask:0xf
    s_nop 1
    v_add_f32_dpp v52, v52, v52 row_ror:8 row_mask:0xf bank_mask:0xf
    v_rcp_f32 v52, v52
    s_nop 0
    v_pk_mul_f32 v[14:15], v[14:15], v[52:53] op_sel_hi:[1,0]
    s_branch L_chk1
L_poll1:
    buffer_load_dwordx4 v[56:59], v50, s[28:31], s67 offen sc1
    buffer_load_dwordx4 v[60:63], v50, s[28:31], s67 offen offset:1024 sc1
    s_sub_u32 s63, s63, 1
    s_cbranch_scc1 L_fin
L_chk1:
    s_waitcnt vmcnt(0)
L_chk1b:
    v_bitop3_b32 v51, v59, v63, v6 bitop3:0x7e
    v_pk_mul_f32 v[18:19], v[56:57], v[14:15] op_sel_hi:[1,0]
    v_cmp_ne_u32 vcc, 0, v51
    v_mul_f32 v20, v58, v14
    v_pk_fma_f32 v[18:19], v[60:61], v[14:15], v[18:19] op_sel:[0,1,0]
    v_fmac_f32 v20, v62, v15
    s_cbranch_vccnz L_poll1
    v_add_f32_dpp v18, v18, v18 row_half_mirror row_mask:0xf bank_mask:0xf
    v_add_f32_dpp v19, v19, v19 row_half_mirror row_mask:0xf bank_mask:0xf
    v_add_f32_dpp v20, v20, v20 row_half_mirror row_mask:0xf bank_mask:0xf
    v_add_f32_dpp v18, v18, v18 row_ror:8 row_mask:0xf bank_mask:0xf
    v_add_f32_dpp v19, v19, v19 row_ror:8 row_mask:0xf bank_mask:0xf
    v_add_f32_dpp v20, v20, v20 row_ror:8 row_mask:0xf bank_mask:0xf
    v_cvt_pk_bf16_f32 v18, v18, 0
    v_cvt_pk_bf16_f32 v19, v19, 0
    v_cvt_pk_bf16_f32 v20, v20, 0
    v_mov_b32_dpp v160, v18 quad_perm:[0,0,0,0] row_mask:0xf bank_mask:0x3
    v_mov_b32_dpp v161, v18 quad_perm:[0,0,0,0] row_mask:0xf bank_mask:0xc
    v_mov_b32_dpp v162, v18 quad_perm:[1,1,1,1] row_mask:0xf bank_mask:0x3
    v_mov_b32_dpp v163, v18 quad_perm:[1,1,1,1] row_mask:0xf bank_mask:0xc
    v_mov_b32_dpp v164, v19 quad_perm:[0,0,0,0] row_mask:0xf bank_mask:0x3
    v_mov_b32_dpp v165, v19 quad_perm:[0,0,0,0] row_mask:0xf bank_mask:0xc
    v_smfmac_f32_16x16x64_bf16 v[36:39], v[160:163], v[64:71], v12
    v_mov_b32_dpp v166, v19 quad_perm:[1,1,1,1] row_mask:0xf bank_mask:0x3
    v_mov_b32_dpp v167, v19 quad_perm:[1,1,1,1] row_mask:0xf bank_mask:0xc
    v_smfmac_f32_16x16x64_bf16 v[40:43], v[160:163], v[72:79], v12
    v_mov_b32_dpp v168, v20 quad_perm:[0,0,0,0] row_mask:0xf bank_mask:0x3
    v_mov_b32_dpp v169, v20 quad_perm:[0,0,0,0] row_mask:0xf bank_mask:0xc
    v_smfmac_f32_16x16x64_bf16 v[36:39], v[164:167], v[80:87], v12
    v_mov_b32_dpp v170, v20 quad_perm:[1,1,1,1] row_mask:0xf bank_mask:0x3
    v_mov_b32_dpp v171, v20 quad_perm:[1,1,1,1] row_mask:0xf bank_mask:0xc
    v_smfmac_f32_16x16x64_bf16 v[40:43], v[164:167], v[88:95], v12
    s_nop 0
    v_smfmac_f32_16x16x64_bf16 v[36:39], v[168:171], v[96:103], v12
    v_smfmac_f32_16x16x64_bf16 v[40:43], v[168:171], v[104:111], v12
    s_mov_b64 exec, s[14:15]
    s_nop 5
    ds_write_b128 v7, v[36:39]
    s_not_b64 exec, exec
    ds_write_b128 v7, v[40:43]
    s_mov_b64 exec, -1
    s_waitcnt lgkmcnt(0)
    s_barrier
    ds_read2st64_b32 v[22:23], v8 offset0:0 offset1:5
    ds_read2st64_b32 v[24:25], v8 offset0:10 offset1:15
    s_waitcnt lgkmcnt(0)
    v_pk_add_f32 v[22:23], v[22:23], v[24:25]
    v_add_f32 v22, v22, v23
    s_nop 1
    v_add_f32_dpp v22, v22, v22 quad_perm:[1,0,3,2] row_mask:0xf bank_mask:0xf
    v_cndmask_b32 v24, v22, 1.0, s[12:13]
    buffer_atomic_add_f32 v24, v9, s[28:31], s5 offen sc0 sc1
    s_waitcnt vmcnt(0)
    v_cmp_eq_f32 vcc, v24, v11
    v_add_f32 v22, v22, v24
    v_cvt_pk_bf16_f32 v22, v22, v22
    s_lshr_b64 exec, vcc, 1
    buffer_store_short v22, v0, s[48:51], s65 offen
    s_cmp_lg_u32 s65, 0
    s_cbranch_scc1 L_atd
    s_and_b64 exec, exec, 1
    s_cbranch_execz L_atd
    s_mov_b32 s58, 655360
    buffer_store_dword v6, v0, s[28:31], s58 offen
L_atd:
L_cons:
L_fin:
L_end:
    s_endpgm
.section .rodata,"a"
.p2align 6
.amdhsa_kernel standalone__sliding_block_cached__decode_kernel
  .amdhsa_next_free_vgpr 256
  .amdhsa_next_free_sgpr 96
  .amdhsa_accum_offset 256
  .amdhsa_group_segment_fixed_size 0
  .amdhsa_kernarg_size 64
  .amdhsa_user_sgpr_count 2
  .amdhsa_user_sgpr_kernarg_segment_ptr 1
  .amdhsa_system_sgpr_workgroup_id_x 1
  .amdhsa_float_denorm_mode_32 3
.end_amdhsa_kernel
```
